```python
import torch

def _softmax(x, axis=-1):
    return torch.softmax(x, dim=axis)
def _gelu(x):
    return torch.nn.functional.gelu(x, approximate="tanh")
def _silu(x):
    return torch.nn.functional.silu(x)
def _sigmoid(x):
    return torch.sigmoid(x)
def _layernorm(x, axis=-1, eps=1e-5):
    m = x.mean(dim=axis, keepdim=True)
    v = x.var(dim=axis, keepdim=True, unbiased=False)
    return (x - m) / torch.sqrt(v + eps)
def _scatter_add(tgt, idx, src, axis=0):
    return tgt.clone().index_add_(axis, idx, src)
def _segment_sum(src, seg, n):
    out = torch.zeros((n,) + src.shape[1:], dtype=src.dtype)
    return out.index_add_(0, seg, src)
def _pad(x, pw):
    flat = tuple(v for pair in reversed(pw) for v in pair)
    return torch.nn.functional.pad(x, flat)

kernel_name = 'standalone__kv_cache_quant_int4_int2_kv_with_per_channel_or_per_token_scales__decode'

def setup_inputs():

    _w = (lambda a: (lambda t: t.to(torch.bfloat16) if t.is_floating_point() else t)(torch.as_tensor(a)))
    B = 2
    Sq = 1
    Skv = 32768
    Hq = 32
    Hkv = 8
    Dh = 128
    bits = 8
    G = 128
    if G <= 0 or G >= Skv:
        G = max(1, Skv // 2)
    Skv = (Skv // G) * G
    ngk = Skv // G
    qmax = (1 << bits) - 1
    return {
        "q": _w((lambda *s: torch.randn(*s, dtype=torch.bfloat16) * 0.4)(B, Hq, Sq, Dh)),
        "qk": _w(torch.randint(0, qmax + 1, (B, Hkv, Skv, Dh)).to(torch.int32)),
        "qv": _w(torch.randint(0, qmax + 1, (B, Hkv, Skv, Dh)).to(torch.int32)),
        "k_scales": _w(torch.abs((lambda *s: torch.randn(*s, dtype=torch.bfloat16) * 0.4)(B, Hkv, ngk, Dh)) * 0.05 + 0.02),
        "k_zeros": _w((lambda *s: torch.randn(*s, dtype=torch.bfloat16) * 0.4)(B, Hkv, ngk, Dh) + float(qmax) / 2.0),
        "v_scales": _w(torch.abs((lambda *s: torch.randn(*s, dtype=torch.bfloat16) * 0.05)(B, Hkv, Skv, 1)) * 0.05 + 0.02),
        "v_zeros": _w((lambda *s: torch.randn(*s, dtype=torch.bfloat16) * 0.05)(B, Hkv, Skv, 1) + float(qmax) / 2.0),
    }

def reference(q, qk, qv, k_scales, k_zeros, v_scales, v_zeros):
    B, Hq, Sq, Dh = q.shape
    Hkv, Skv = qk.shape[1], qk.shape[2]
    ngk = k_scales.shape[2]
    G = Skv // ngk
    ks = (lambda x, n, axis: torch.repeat_interleave(x, n, dim=axis))(k_scales, G, axis=2)
    kz = (lambda x, n, axis: torch.repeat_interleave(x, n, dim=axis))(k_zeros, G, axis=2)
    k = ((lambda x, dt: x.to(dt))(qk, q.dtype) - kz) * ks
    v = ((lambda x, dt: x.to(dt))(qv, q.dtype) - v_zeros) * v_scales
    rep = Hq // Hkv
    if rep > 1:
        k = (lambda x, n, axis: torch.repeat_interleave(x, n, dim=axis))(k, rep, axis=1)
        v = (lambda x, n, axis: torch.repeat_interleave(x, n, dim=axis))(v, rep, axis=1)
    scale = float(Dh) ** -0.5
    logits = torch.einsum("bhqd,bhkd->bhqk", q, k) * scale
    p = _softmax(logits, axis=-1)
    o = torch.einsum("bhqk,bhkd->bhqd", p, v)
    return o
```

```asm
; @launch grid=(256,1,1) block=(256,1,1) lds=83968
.amdgcn_target "amdgcn-amd-amdhsa--gfx950"
.text
.globl standalone__kv_cache_quant_int4_int2_kv_with_per_channel_or_per_token_scales__decode_kernel
.p2align 8
.type standalone__kv_cache_quant_int4_int2_kv_with_per_channel_or_per_token_scales__decode_kernel,@function
standalone__kv_cache_quant_int4_int2_kv_with_per_channel_or_per_token_scales__decode_kernel:
s_cmp_ge_u32 s2, 256
s_cbranch_scc1 L_end
s_load_dwordx16 s[4:19], s[0:1], 0
s_load_dwordx4 s[20:23], s[0:1], 64
v_lshrrev_b32 v18, 6, v0
v_and_b32 v1, 63, v0
s_and_b32 s52, s2, 7
v_readfirstlane_b32 s3, v18
s_lshl_b32 s52, s52, 1
s_lshr_b32 s53, s2, 3
s_and_b32 s60, s53, 1
s_add_u32 s52, s52, s60
s_lshr_b32 s53, s2, 4
v_and_b32 v19, 15, v1
v_lshrrev_b32 v20, 4, v1
v_lshlrev_b32 v21, 9, v19
v_lshl_add_u32 v2, v20, 4, v21
v_and_b32 v21, 7, v1
v_lshlrev_b32 v21, 9, v21
v_lshrrev_b32 v22, 3, v1
v_lshl_add_u32 v7, v22, 4, v21
v_lshlrev_b32 v5, 4, v19
v_lshl_add_u32 v3, v20, 11, v5
v_lshlrev_b32 v4, 3, v20
v_lshlrev_b32 v6, 2, v1
s_lshr_b32 s60, s53, 1
s_mul_i32 s58, s60, 2097152
s_and_b32 s60, s53, 1
s_mul_i32 s60, s60, 32768
s_add_u32 s58, s58, s60
s_lshr_b32 s60, s2, 3
s_xor_b32 s60, s60, s3
s_and_b32 s60, s60, 3
s_lshl_b32 s60, s60, 13
s_add_u32 s58, s58, s60
s_and_b32 s63, s52, 1
s_mul_i32 s63, s63, 16
s_and_b32 s60, s2, 7
s_add_u32 s63, s63, s60
s_mul_i32 s63, s63, 65536
s_and_b32 s63, s63, 2097151
s_mov_b32 s62, s63
s_add_u32 s54, s58, s62
s_lshr_b32 s56, s54, 8
s_and_b32 s56, s56, 0xffffff00
s_add_u32 s57, s54, 4096
s_waitcnt lgkmcnt(0)
s_lshl_b32 s60, s52, 10
s_add_u32 s48, s4, s60
s_addc_u32 s49, s5, 0
s_and_b32 s49, s49, 0xffff
s_mov_b32 s50, 1024
s_mov_b32 s51, 0x20000
v_lshl_add_u32 v21, v20, 8, v5
buffer_load_dwordx4 v[48:51], v21, s[48:51], 0 offen nt
s_lshl_b32 s60, s52, 16
s_add_u32 s32, s10, s60
s_addc_u32 s33, s11, 0
s_and_b32 s33, s33, 0xffff
s_mov_b32 s34, 65536
s_mov_b32 s35, 0x20000
s_lshl_b32 s60, s52, 16
s_add_u32 s36, s12, s60
s_addc_u32 s37, s13, 0
s_and_b32 s37, s37, 0xffff
s_mov_b32 s38, 65536
s_mov_b32 s39, 0x20000
s_lshl_b32 s60, s52, 24
s_add_u32 s24, s6, s60
s_addc_u32 s25, s7, 0
s_and_b32 s25, s25, 0xffff
s_mov_b32 s26, 16777216
s_mov_b32 s27, 0x20000
buffer_load_dwordx4 v[36:39], v5, s[32:35], s56 offen nt
buffer_load_dword v40, v6, s[36:39], s56 offen nt
buffer_load_dwordx4 v[128:131], v2, s[24:27], s54 offen offset:0 nt
buffer_load_dwordx4 v[132:135], v2, s[24:27], s54 offen offset:64 nt
buffer_load_dwordx4 v[136:139], v7, s[24:27], s54 offen offset:128 nt
buffer_load_dwordx4 v[140:143], v7, s[24:27], s57 offen offset:128 nt
buffer_load_dwordx4 v[144:147], v7, s[24:27], s54 offen offset:256 nt
buffer_load_dwordx4 v[148:151], v7, s[24:27], s57 offen offset:256 nt
buffer_load_dwordx4 v[152:155], v7, s[24:27], s54 offen offset:384 nt
buffer_load_dwordx4 v[156:159], v7, s[24:27], s57 offen offset:384 nt
s_lshl_b32 s60, s52, 16
s_add_u32 s40, s14, s60
s_addc_u32 s41, s15, 0
s_and_b32 s41, s41, 0xffff
s_mov_b32 s42, 65536
s_mov_b32 s43, 0x20000
s_lshl_b32 s60, s52, 16
s_add_u32 s44, s16, s60
s_addc_u32 s45, s17, 0
s_and_b32 s45, s45, 0xffff
s_mov_b32 s46, 65536
s_mov_b32 s47, 0x20000
s_lshl_b32 s60, s52, 24
s_add_u32 s28, s8, s60
s_addc_u32 s29, s9, 0
s_and_b32 s29, s29, 0xffff
s_mov_b32 s30, 16777216
s_mov_b32 s31, 0x20000
s_mul_i32 s60, s3, 1536
v_mul_u32_u24 v21, 288, v20
v_add3_u32 v10, v21, v5, s60
v_add_u32 v11, s60, v6
v_add_u32 v11, 1152, v11
v_and_b32 v22, 3, v1
v_mul_u32_u24 v21, 288, v22
v_add3_u32 v12, v21, v4, s60
v_add_u32 v13, s60, v4
v_add_u32 v13, 1152, v13
v_add_u32 v8, v12, v4
v_add_u32 v9, v13, v4
s_mul_i32 s60, s3, 8192
s_add_u32 s60, s60, 6144
v_lshlrev_b32 v22, 4, v22
v_lshl_add_u32 v14, v20, 6, v22
v_add_u32 v14, s60, v14
s_mov_b32 s64, 0xffff0000
s_mov_b32 s68, 0x000f000f
s_mov_b32 s69, 0x000f000f
v_mov_b32 v15, 0xff800000
v_mov_b32 v16, 0
v_mov_b32 v60, 0
v_mov_b32 v61, 0
v_mov_b32 v62, 0
v_mov_b32 v63, 0
v_mov_b32 v64, 0
v_mov_b32 v65, 0
v_mov_b32 v66, 0
v_mov_b32 v67, 0
v_mov_b32 v68, 0
v_mov_b32 v69, 0
v_mov_b32 v70, 0
v_mov_b32 v71, 0
v_mov_b32 v72, 0
v_mov_b32 v73, 0
v_mov_b32 v74, 0
v_mov_b32 v75, 0
v_mov_b32 v76, 0
v_mov_b32 v77, 0
v_mov_b32 v78, 0
v_mov_b32 v79, 0
v_mov_b32 v80, 0
v_mov_b32 v81, 0
v_mov_b32 v82, 0
v_mov_b32 v83, 0
v_mov_b32 v84, 0
v_mov_b32 v85, 0
v_mov_b32 v86, 0
v_mov_b32 v87, 0
v_mov_b32 v88, 0
v_mov_b32 v89, 0
v_mov_b32 v90, 0
v_mov_b32 v91, 0
v_mov_b32 v92, 0
v_mov_b32 v93, 0
v_mov_b32 v94, 0
v_mov_b32 v95, 0
s_mov_b32 s61, 0x3e0293ee
s_mov_b32 s59, 31
s_waitcnt vmcnt(10)
v_lshlrev_b32 v28, 16, v48
v_and_b32 v29, s64, v48
v_lshlrev_b32 v30, 16, v49
v_and_b32 v31, s64, v49
v_lshlrev_b32 v32, 16, v50
v_and_b32 v33, s64, v50
v_lshlrev_b32 v34, 16, v51
v_and_b32 v35, s64, v51
v_mul_f32 v28, s61, v28
v_mul_f32 v29, s61, v29
v_mul_f32 v30, s61, v30
v_mul_f32 v31, s61, v31
v_mul_f32 v32, s61, v32
v_mul_f32 v33, s61, v33
v_mul_f32 v34, s61, v34
v_mul_f32 v35, s61, v35
L_kloop:
s_waitcnt vmcnt(8)
v_lshlrev_b32 v18, 16, v36
v_and_b32 v19, s64, v36
v_mul_f32 v18, v18, v28
v_mul_f32 v19, v19, v29
v_cvt_pk_bf16_f32 v48, v18, v19
v_lshlrev_b32 v18, 16, v37
v_and_b32 v19, s64, v37
v_mul_f32 v18, v18, v30
v_mul_f32 v19, v19, v31
v_cvt_pk_bf16_f32 v49, v18, v19
v_lshlrev_b32 v18, 16, v38
v_and_b32 v19, s64, v38
v_mul_f32 v18, v18, v32
v_mul_f32 v19, v19, v33
v_cvt_pk_bf16_f32 v50, v18, v19
v_lshlrev_b32 v18, 16, v39
v_and_b32 v19, s64, v39
v_mul_f32 v18, v18, v34
v_mul_f32 v19, v19, v35
v_cvt_pk_bf16_f32 v51, v18, v19
v_xor_b32 v20, 0x80008000, v40
ds_write_b128 v10, v[48:51]
ds_write_b32 v11, v20
s_cmp_eq_u32 s59, 0
s_cbranch_scc1 L_k2v_small
s_add_u32 s62, s62, 65536
s_and_b32 s62, s62, 2097151
s_add_u32 s54, s58, s62
s_lshr_b32 s56, s54, 8
s_and_b32 s56, s56, 0xffffff00
s_add_u32 s57, s54, 4096
buffer_load_dwordx4 v[36:39], v5, s[32:35], s56 offen nt
buffer_load_dword v40, v6, s[36:39], s56 offen nt
L_k2v_small_back:
ds_read2_b64 v[96:99], v12 offset0:0 offset1:4
ds_read_b128 v[100:103], v8 offset:64
ds_read_b128 v[104:107], v8 offset:128
ds_read_b128 v[108:111], v8 offset:192
ds_read2_b64 v[112:115], v13 offset0:0 offset1:4
ds_read_b128 v[116:119], v9 offset:64
ds_read_b128 v[120:123], v9 offset:128
ds_read_b128 v[124:127], v9 offset:192
s_waitcnt lgkmcnt(0)
v_mfma_f32_16x16x32_bf16 v[56:59], v[112:115], v[96:99], 0
v_mfma_f32_16x16x32_bf16 v[56:59], v[116:119], v[100:103], v[56:59]
v_mfma_f32_16x16x32_bf16 v[56:59], v[120:123], v[104:107], v[56:59]
v_mfma_f32_16x16x32_bf16 v[56:59], v[124:127], v[108:111], v[56:59]
s_waitcnt vmcnt(2)
v_cvt_f32_i32 v128, v128
v_cvt_f32_i32 v129, v129
v_cvt_f32_i32 v130, v130
v_cvt_f32_i32 v131, v131
v_cvt_pk_bf16_f32 v112, v128, v129
v_cvt_pk_bf16_f32 v113, v130, v131
v_cvt_f32_i32 v132, v132
v_cvt_f32_i32 v133, v133
v_cvt_f32_i32 v134, v134
v_cvt_f32_i32 v135, v135
v_cvt_pk_bf16_f32 v114, v132, v133
v_cvt_pk_bf16_f32 v115, v134, v135
v_cvt_f32_i32 v136, v136
v_cvt_f32_i32 v137, v137
v_cvt_f32_i32 v138, v138
v_cvt_f32_i32 v139, v139
v_cvt_pk_bf16_f32 v116, v136, v137
v_cvt_pk_bf16_f32 v117, v138, v139
v_cvt_f32_i32 v140, v140
v_cvt_f32_i32 v141, v141
v_cvt_f32_i32 v142, v142
v_cvt_f32_i32 v143, v143
v_cvt_pk_bf16_f32 v118, v140, v141
v_cvt_pk_bf16_f32 v119, v142, v143
v_cvt_f32_i32 v144, v144
v_cvt_f32_i32 v145, v145
v_cvt_f32_i32 v146, v146
v_cvt_f32_i32 v147, v147
v_cvt_pk_bf16_f32 v120, v144, v145
v_cvt_pk_bf16_f32 v121, v146, v147
v_cvt_f32_i32 v148, v148
v_cvt_f32_i32 v149, v149
v_cvt_f32_i32 v150, v150
v_cvt_f32_i32 v151, v151
v_cvt_pk_bf16_f32 v122, v148, v149
v_cvt_pk_bf16_f32 v123, v150, v151
v_cvt_f32_i32 v152, v152
v_cvt_f32_i32 v153, v153
v_cvt_f32_i32 v154, v154
v_cvt_f32_i32 v155, v155
v_cvt_pk_bf16_f32 v124, v152, v153
v_cvt_pk_bf16_f32 v125, v154, v155
v_cvt_f32_i32 v156, v156
v_cvt_f32_i32 v157, v157
v_cvt_f32_i32 v158, v158
v_cvt_f32_i32 v159, v159
v_cvt_pk_bf16_f32 v126, v156, v157
v_cvt_pk_bf16_f32 v127, v158, v159
s_cmp_eq_u32 s59, 0
s_cbranch_scc1 L_k2v_big
buffer_load_dwordx4 v[128:131], v2, s[24:27], s54 offen offset:0 nt
buffer_load_dwordx4 v[132:135], v2, s[24:27], s54 offen offset:64 nt
buffer_load_dwordx4 v[136:139], v7, s[24:27], s54 offen offset:128 nt
buffer_load_dwordx4 v[140:143], v7, s[24:27], s57 offen offset:128 nt
buffer_load_dwordx4 v[144:147], v7, s[24:27], s54 offen offset:256 nt
buffer_load_dwordx4 v[148:151], v7, s[24:27], s57 offen offset:256 nt
buffer_load_dwordx4 v[152:155], v7, s[24:27], s54 offen offset:384 nt
buffer_load_dwordx4 v[156:159], v7, s[24:27], s57 offen offset:384 nt
L_k2v_big_back:
v_mov_b32 v18, v116
v_mov_b32 v19, v117
s_nop 0
v_mov_b32_dpp v116, v118 row_ror:8 row_mask:0xf bank_mask:0xc
v_mov_b32_dpp v117, v119 row_ror:8 row_mask:0xf bank_mask:0xc
v_mov_b32_dpp v118, v18 row_ror:8 row_mask:0xf bank_mask:0x3
v_mov_b32_dpp v119, v19 row_ror:8 row_mask:0xf bank_mask:0x3
v_mov_b32 v18, v120
v_mov_b32 v19, v121
s_nop 0
v_mov_b32_dpp v120, v122 row_ror:8 row_mask:0xf bank_mask:0xc
v_mov_b32_dpp v121, v123 row_ror:8 row_mask:0xf bank_mask:0xc
v_mov_b32_dpp v122, v18 row_ror:8 row_mask:0xf bank_mask:0x3
v_mov_b32_dpp v123, v19 row_ror:8 row_mask:0xf bank_mask:0x3
v_mov_b32 v18, v124
v_mov_b32 v19, v125
s_nop 0
v_mov_b32_dpp v124, v126 row_ror:8 row_mask:0xf bank_mask:0xc
v_mov_b32_dpp v125, v127 row_ror:8 row_mask:0xf bank_mask:0xc
v_mov_b32_dpp v126, v18 row_ror:8 row_mask:0xf bank_mask:0x3
v_mov_b32_dpp v127, v19 row_ror:8 row_mask:0xf bank_mask:0x3
s_nop 1
v_mfma_f32_16x16x32_bf16 v[56:59], v[112:115], v[96:99], v[56:59]
v_mfma_f32_16x16x32_bf16 v[56:59], v[116:119], v[100:103], v[56:59]
v_mfma_f32_16x16x32_bf16 v[56:59], v[120:123], v[104:107], v[56:59]
v_mfma_f32_16x16x32_bf16 v[56:59], v[124:127], v[108:111], v[56:59]
s_nop 7
s_mov_b64 exec, s[68:69]
ds_write_b128 v14, v[56:59]
s_mov_b64 exec, -1
v_max3_f32 v15, v56, v57, v15
v_max3_f32 v15, v58, v59, v15
v_add_u32 v14, 256, v14
s_sub_u32 s59, s59, 1
s_cbranch_scc0 L_kloop
v_subrev_u32 v14, 8192, v14
v_mov_b32 v19, v15
ds_read_b128 v[56:59], v14
s_nop 0
v_permlane16_swap_b32 v15, v19
v_max_f32 v15, v15, v19
v_mov_b32 v19, v15
s_nop 1
v_permlane32_swap_b32 v15, v19
v_max_f32 v15, v15, v19
s_mov_b32 s59, 31
L_vloop:
s_waitcnt vmcnt(8) lgkmcnt(0)
v_lshlrev_b32 v22, 16, v42
v_and_b32 v23, s64, v42
v_lshlrev_b32 v24, 16, v43
v_and_b32 v25, s64, v43
v_sub_f32 v56, v56, v15
v_sub_f32 v57, v57, v15
v_sub_f32 v58, v58, v15
v_sub_f32 v59, v59, v15
v_exp_f32 v56, v56
v_exp_f32 v57, v57
v_exp_f32 v58, v58
v_exp_f32 v59, v59
s_nop 0
v_add_f32 v18, v56, v57
v_add_f32 v19, v58, v59
v_mul_f32 v56, v56, v22
v_mul_f32 v57, v57, v23
v_mul_f32 v58, v58, v24
v_mul_f32 v59, v59, v25
v_add_f32 v16, v16, v18
v_cvt_pk_bf16_f32 v52, v56, v57
v_cvt_pk_bf16_f32 v53, v58, v59
v_add_f32 v16, v16, v19
s_nop 0
v_mfma_f32_16x16x16_bf16 v[60:63], v[52:53], v[44:45], v[60:63]
s_cmp_eq_u32 s59, 0
s_cbranch_scc1 L_vlast
s_add_u32 s62, s62, 65536
s_and_b32 s62, s62, 2097151
s_add_u32 s54, s58, s62
s_lshr_b32 s55, s54, 8
buffer_load_dwordx2 v[42:43], v4, s[40:43], s55 offen nt
buffer_load_dwordx2 v[44:45], v4, s[44:47], s55 offen nt
v_add_u32 v14, 256, v14
ds_read_b128 v[56:59], v14
L_vlast_back:
s_waitcnt vmcnt(6)
v_cvt_f32_i32 v128, v128
v_cvt_f32_i32 v132, v132
v_cvt_pk_bf16_f32 v112, v128, v132
v_cvt_f32_i32 v129, v129
v_cvt_f32_i32 v133, v133
v_cvt_pk_bf16_f32 v114, v129, v133
v_cvt_f32_i32 v130, v130
v_cvt_f32_i32 v134, v134
v_cvt_pk_bf16_f32 v116, v130, v134
v_cvt_f32_i32 v131, v131
v_cvt_f32_i32 v135, v135
v_cvt_pk_bf16_f32 v118, v131, v135
v_cvt_f32_i32 v136, v136
v_cvt_f32_i32 v140, v140
v_cvt_pk_bf16_f32 v120, v136, v140
v_cvt_f32_i32 v137, v137
v_cvt_f32_i32 v141, v141
v_cvt_pk_bf16_f32 v122, v137, v141
v_cvt_f32_i32 v138, v138
v_cvt_f32_i32 v142, v142
v_cvt_pk_bf16_f32 v124, v138, v142
v_cvt_f32_i32 v139, v139
v_cvt_f32_i32 v143, v143
v_cvt_pk_bf16_f32 v126, v139, v143
s_waitcnt vmcnt(2)
v_cvt_f32_i32 v144, v144
v_cvt_f32_i32 v148, v148
v_cvt_pk_bf16_f32 v113, v144, v148
v_cvt_f32_i32 v145, v145
v_cvt_f32_i32 v149, v149
v_cvt_pk_bf16_f32 v115, v145, v149
v_cvt_f32_i32 v146, v146
v_cvt_f32_i32 v150, v150
v_cvt_pk_bf16_f32 v117, v146, v150
v_cvt_f32_i32 v147, v147
v_cvt_f32_i32 v151, v151
v_cvt_pk_bf16_f32 v119, v147, v151
v_cvt_f32_i32 v152, v152
v_cvt_f32_i32 v156, v156
v_cvt_pk_bf16_f32 v121, v152, v156
v_cvt_f32_i32 v153, v153
v_cvt_f32_i32 v157, v157
v_cvt_pk_bf16_f32 v123, v153, v157
v_cvt_f32_i32 v154, v154
v_cvt_f32_i32 v158, v158
v_cvt_pk_bf16_f32 v125, v154, v158
v_cvt_f32_i32 v155, v155
v_cvt_f32_i32 v159, v159
v_cvt_pk_bf16_f32 v127, v155, v159
s_cmp_eq_u32 s59, 0
s_cbranch_scc1 L_vnoload
buffer_load_dwordx4 v[128:131], v3, s[28:31], s54 offen offset:0 nt
buffer_load_dwordx4 v[132:135], v3, s[28:31], s54 offen offset:512 nt
buffer_load_dwordx4 v[136:139], v3, s[28:31], s54 offen offset:256 nt
buffer_load_dwordx4 v[140:143], v3, s[28:31], s54 offen offset:768 nt
buffer_load_dwordx4 v[144:147], v3, s[28:31], s54 offen offset:1024 nt
buffer_load_dwordx4 v[148:151], v3, s[28:31], s54 offen offset:1536 nt
buffer_load_dwordx4 v[152:155], v3, s[28:31], s54 offen offset:1280 nt
buffer_load_dwordx4 v[156:159], v3, s[28:31], s54 offen offset:1792 nt
L_vnoload:
s_nop 0
v_mfma_f32_16x16x16_bf16 v[64:67], v[52:53], v[112:113], v[64:67]
v_mfma_f32_16x16x16_bf16 v[68:71], v[52:53], v[114:115], v[68:71]
v_mfma_f32_16x16x16_bf16 v[72:75], v[52:53], v[116:117], v[72:75]
v_mfma_f32_16x16x16_bf16 v[76:79], v[52:53], v[118:119], v[76:79]
v_mfma_f32_16x16x16_bf16 v[80:83], v[52:53], v[120:121], v[80:83]
v_mfma_f32_16x16x16_bf16 v[84:87], v[52:53], v[122:123], v[84:87]
v_mfma_f32_16x16x16_bf16 v[88:91], v[52:53], v[124:125], v[88:91]
v_mfma_f32_16x16x16_bf16 v[92:95], v[52:53], v[126:127], v[92:95]
s_barrier
s_sub_u32 s59, s59, 1
s_cbranch_scc0 L_vloop
s_lshl_b32 s60, s3, 11
s_add_u32 s60, s60, 38912
v_add_u32 v18, s60, v5
v_lshlrev_b32 v19, 2, v0
v_add_u32 v20, 38912, v19
s_mov_b64 exec, 0xffff
s_nop 1
ds_write_b128 v18, v[64:67] offset:0
ds_write_b128 v18, v[68:71] offset:256
ds_write_b128 v18, v[72:75] offset:512
ds_write_b128 v18, v[76:79] offset:768
ds_write_b128 v18, v[80:83] offset:1024
ds_write_b128 v18, v[84:87] offset:1280
ds_write_b128 v18, v[88:91] offset:1536
ds_write_b128 v18, v[92:95] offset:1792
s_mov_b64 exec, -1
s_lshl_b32 s61, s52, 4
s_add_u32 s61, s61, s53
s_mul_i32 s61, s61, 4096
s_add_u32 s48, s22, s61
s_addc_u32 s49, s23, 0
s_and_b32 s49, s49, 0xffff
s_mov_b32 s50, 4096
s_mov_b32 s51, 0x20000
s_waitcnt lgkmcnt(0)
s_barrier
ds_read_b32 v128, v20 offset:0
ds_read_b32 v129, v20 offset:2048
ds_read_b32 v130, v20 offset:4096
ds_read_b32 v131, v20 offset:6144
ds_read_b32 v132, v20 offset:1024
ds_read_b32 v133, v20 offset:3072
ds_read_b32 v134, v20 offset:5120
ds_read_b32 v135, v20 offset:7168
s_waitcnt lgkmcnt(4)
v_fma_f32 v144, v96, v128, -v38
v_fmac_f32 v144, v97, v129
v_fmac_f32 v144, v98, v130
v_fmac_f32 v144, v99, v131
s_waitcnt lgkmcnt(0)
v_fma_f32 v145, v96, v132, -v38
v_fmac_f32 v145, v97, v133
v_fmac_f32 v145, v98, v134
v_fmac_f32 v145, v99, v135
buffer_store_dword v144, v19, s[48:51], 0 offen offset:0 sc1
buffer_store_dword v145, v19, s[48:51], 0 offen offset:1024 sc1
v_cmp_gt_u32 vcc, 4, v0
s_and_saveexec_b64 s[66:67], vcc
s_cbranch_execz L_nost
buffer_store_dword v36, v19, s[48:51], 0 offen offset:2048 sc1
buffer_store_dword v37, v19, s[48:51], 0 offen offset:2064 sc1
L_nost:
s_mov_b64 exec, s[66:67]
s_mov_b32 s32, s20
s_and_b32 s33, s21, 0xffff
s_mov_b32 s34, 256
s_lshl_b32 s56, s52, 4
s_mul_i32 s61, s52, 65536
s_add_u32 s28, s22, s61
s_addc_u32 s29, s23, 0
s_and_b32 s29, s29, 0xffff
s_mov_b32 s30, 65536
s_lshl_b32 s61, s52, 10
s_add_u32 s24, s18, s61
s_addc_u32 s25, s19, 0
s_and_b32 s25, s25, 0xffff
s_mov_b32 s26, 1024
v_and_b32 v21, 3, v1
v_lshlrev_b32 v21, 6, v21
v_and_b32 v20, 15, v1
v_lshlrev_b32 v20, 12, v20
v_lshrrev_b32 v24, 4, v1
v_lshl_add_u32 v20, v24, 2, v20
v_add_u32 v24, 0, v0
v_and_b32 v22, 3, v24
v_lshlrev_b32 v22, 7, v22
v_lshrrev_b32 v25, 8, v24
v_lshl_add_u32 v22, v25, 6, v22
v_bfe_u32 v25, v24, 2, 4
v_lshl_add_u32 v22, v25, 2, v22
v_bfe_u32 v25, v24, 6, 2
v_add_u32 v22, v22, v25
v_lshlrev_b32 v22, 1, v22
v_add_u32 v24, 256, v0
v_and_b32 v23, 3, v24
v_lshlrev_b32 v23, 7, v23
v_lshrrev_b32 v25, 8, v24
v_lshl_add_u32 v23, v25, 6, v23
v_bfe_u32 v25, v24, 2, 4
v_lshl_add_u32 v23, v25, 2, v23
v_bfe_u32 v25, v24, 6, 2
v_add_u32 v23, v23, v25
v_lshlrev_b32 v23, 1, v23
v_mov_b32 v24, 47296
s_waitcnt vmcnt(0)
s_barrier
s_cmp_lg_u32 s3, 0
s_cbranch_scc1 L_noat
s_mov_b64 exec, 1
v_mov_b32 v25, 1
v_mov_b32 v18, 0
buffer_atomic_add v25, v18, s[32:35], s56 offen sc0
s_waitcnt vmcnt(0)
ds_write_b32 v24, v25
s_mov_b64 exec, -1
s_waitcnt lgkmcnt(0)
L_noat:
s_barrier
ds_read_b32 v25, v24
s_waitcnt lgkmcnt(0)
v_readfirstlane_b32 s60, v25
s_nop 3
s_cmp_lg_u32 s60, 15
s_cbranch_scc1 L_notlast
buffer_load_dword v96, v20, s[28:31], 0 offen offset:2048 sc1
buffer_load_dword v97, v20, s[28:31], 0 offen offset:2064 sc1
s_mov_b32 s61, 0
buffer_load_dword v64, v19, s[28:31], s61 offen offset:0 sc1
buffer_load_dword v65, v19, s[28:31], s61 offen offset:1024 sc1
s_mov_b32 s61, 4096
buffer_load_dword v66, v19, s[28:31], s61 offen offset:0 sc1
buffer_load_dword v67, v19, s[28:31], s61 offen offset:1024 sc1
s_mov_b32 s61, 8192
buffer_load_dword v68, v19, s[28:31], s61 offen offset:0 sc1
buffer_load_dword v69, v19, s[28:31], s61 offen offset:1024 sc1
s_mov_b32 s61, 12288
buffer_load_dword v70, v19, s[28:31], s61 offen offset:0 sc1
buffer_load_dword v71, v19, s[28:31], s61 offen offset:1024 sc1
s_mov_b32 s61, 16384
buffer_load_dword v72, v19, s[28:31], s61 offen offset:0 sc1
buffer_load_dword v73, v19, s[28:31], s61 offen offset:1024 sc1
s_mov_b32 s61, 20480
buffer_load_dword v74, v19, s[28:31], s61 offen offset:0 sc1
buffer_load_dword v75, v19, s[28:31], s61 offen offset:1024 sc1
s_mov_b32 s61, 24576
buffer_load_dword v76, v19, s[28:31], s61 offen offset:0 sc1
buffer_load_dword v77, v19, s[28:31], s61 offen offset:1024 sc1
s_mov_b32 s61, 28672
buffer_load_dword v78, v19, s[28:31], s61 offen offset:0 sc1
buffer_load_dword v79, v19, s[28:31], s61 offen offset:1024 sc1
s_mov_b32 s61, 32768
buffer_load_dword v80, v19, s[28:31], s61 offen offset:0 sc1
buffer_load_dword v81, v19, s[28:31], s61 offen offset:1024 sc1
s_mov_b32 s61, 36864
buffer_load_dword v82, v19, s[28:31], s61 offen offset:0 sc1
buffer_load_dword v83, v19, s[28:31], s61 offen offset:1024 sc1
s_mov_b32 s61, 40960
buffer_load_dword v84, v19, s[28:31], s61 offen offset:0 sc1
buffer_load_dword v85, v19, s[28:31], s61 offen offset:1024 sc1
s_mov_b32 s61, 45056
buffer_load_dword v86, v19, s[28:31], s61 offen offset:0 sc1
buffer_load_dword v87, v19, s[28:31], s61 offen offset:1024 sc1
s_mov_b32 s61, 49152
buffer_load_dword v88, v19, s[28:31], s61 offen offset:0 sc1
buffer_load_dword v89, v19, s[28:31], s61 offen offset:1024 sc1
s_mov_b32 s61, 53248
buffer_load_dword v90, v19, s[28:31], s61 offen offset:0 sc1
buffer_load_dword v91, v19, s[28:31], s61 offen offset:1024 sc1
s_mov_b32 s61, 57344
buffer_load_dword v92, v19, s[28:31], s61 offen offset:0 sc1
buffer_load_dword v93, v19, s[28:31], s61 offen offset:1024 sc1
s_mov_b32 s61, 61440
buffer_load_dword v94, v19, s[28:31], s61 offen offset:0 sc1
buffer_load_dword v95, v19, s[28:31], s61 offen offset:1024 sc1
s_waitcnt vmcnt(32)
v_mov_b32 v98, v96
s_nop 1
v_max_f32_dpp v98, v98, v98 row_ror:1 row_mask:0xf bank_mask:0xf
s_nop 1
v_max_f32_dpp v98, v98, v98 row_ror:2 row_mask:0xf bank_mask:0xf
s_nop 1
v_max_f32_dpp v98, v98, v98 row_ror:4 row_mask:0xf bank_mask:0xf
s_nop 1
v_max_f32_dpp v98, v98, v98 row_ror:8 row_mask:0xf bank_mask:0xf
v_sub_f32 v96, v96, v98
v_exp_f32 v96, v96
s_nop 0
v_mul_f32 v98, v96, v97
s_nop 1
v_add_f32_dpp v98, v98, v98 row_ror:1 row_mask:0xf bank_mask:0xf
s_nop 1
v_add_f32_dpp v98, v98, v98 row_ror:2 row_mask:0xf bank_mask:0xf
s_nop 1
v_add_f32_dpp v98, v98, v98 row_ror:4 row_mask:0xf bank_mask:0xf
s_nop 1
v_add_f32_dpp v98, v98, v98 row_ror:8 row_mask:0xf bank_mask:0xf
v_rcp_f32 v97, v98
s_nop 0
v_mul_f32 v96, v96, v97
ds_bpermute_b32 v112, v21, v96 offset:0
ds_bpermute_b32 v113, v21, v96 offset:4
ds_bpermute_b32 v114, v21, v96 offset:8
ds_bpermute_b32 v115, v21, v96 offset:12
ds_bpermute_b32 v116, v21, v96 offset:16
ds_bpermute_b32 v117, v21, v96 offset:20
ds_bpermute_b32 v118, v21, v96 offset:24
ds_bpermute_b32 v119, v21, v96 offset:28
ds_bpermute_b32 v120, v21, v96 offset:32
ds_bpermute_b32 v121, v21, v96 offset:36
ds_bpermute_b32 v122, v21, v96 offset:40
ds_bpermute_b32 v123, v21, v96 offset:44
ds_bpermute_b32 v124, v21, v96 offset:48
ds_bpermute_b32 v125, v21, v96 offset:52
ds_bpermute_b32 v126, v21, v96 offset:56
ds_bpermute_b32 v127, v21, v96 offset:60
s_waitcnt vmcnt(0) lgkmcnt(0)
v_mul_f32 v98, v112, v64
v_fmac_f32 v98, v113, v66
v_fmac_f32 v98, v114, v68
v_fmac_f32 v98, v115, v70
v_fmac_f32 v98, v116, v72
v_fmac_f32 v98, v117, v74
v_fmac_f32 v98, v118, v76
v_fmac_f32 v98, v119, v78
v_fmac_f32 v98, v120, v80
v_fmac_f32 v98, v121, v82
v_fmac_f32 v98, v122, v84
v_fmac_f32 v98, v123, v86
v_fmac_f32 v98, v124, v88
v_fmac_f32 v98, v125, v90
v_fmac_f32 v98, v126, v92
v_fmac_f32 v98, v127, v94
v_cvt_pk_bf16_f32 v98, v98, v98
buffer_store_short v98, v22, s[24:27], 0 offen
v_mul_f32 v98, v112, v65
v_fmac_f32 v98, v113, v67
v_fmac_f32 v98, v114, v69
v_fmac_f32 v98, v115, v71
v_fmac_f32 v98, v116, v73
v_fmac_f32 v98, v117, v75
v_fmac_f32 v98, v118, v77
v_fmac_f32 v98, v119, v79
v_fmac_f32 v98, v120, v81
v_fmac_f32 v98, v121, v83
v_fmac_f32 v98, v122, v85
v_fmac_f32 v98, v123, v87
v_fmac_f32 v98, v124, v89
v_fmac_f32 v98, v125, v91
v_fmac_f32 v98, v126, v93
v_fmac_f32 v98, v127, v95
v_cvt_pk_bf16_f32 v98, v98, v98
buffer_store_short v98, v23, s[24:27], 0 offen
L_notlast:
L_end:
s_endpgm
L_k2v_small:
s_mov_b32 s62, s63
s_add_u32 s54, s58, s62
s_lshr_b32 s55, s54, 8
buffer_load_dwordx2 v[42:43], v4, s[40:43], s55 offen nt
buffer_load_dwordx2 v[44:45], v4, s[44:47], s55 offen nt
s_branch L_k2v_small_back
L_k2v_big:
buffer_load_dwordx4 v[128:131], v3, s[28:31], s54 offen offset:0 nt
buffer_load_dwordx4 v[132:135], v3, s[28:31], s54 offen offset:512 nt
buffer_load_dwordx4 v[136:139], v3, s[28:31], s54 offen offset:256 nt
buffer_load_dwordx4 v[140:143], v3, s[28:31], s54 offen offset:768 nt
buffer_load_dwordx4 v[144:147], v3, s[28:31], s54 offen offset:1024 nt
buffer_load_dwordx4 v[148:151], v3, s[28:31], s54 offen offset:1536 nt
buffer_load_dwordx4 v[152:155], v3, s[28:31], s54 offen offset:1280 nt
buffer_load_dwordx4 v[156:159], v3, s[28:31], s54 offen offset:1792 nt
s_branch L_k2v_big_back
L_vlast:
buffer_load_dwordx2 v[42:43], v4, s[40:43], s55 offen nt
buffer_load_dwordx2 v[44:45], v4, s[44:47], s55 offen nt
v_mov_b32 v19, v16
s_nop 1
v_permlane16_swap_b32 v16, v19
v_add_f32 v16, v16, v19
v_mov_b32 v19, v16
s_nop 1
v_permlane32_swap_b32 v16, v19
v_add_f32 v16, v16, v19
s_lshl_b32 s61, s3, 2
s_add_u32 s61, s61, 47104
v_mul_u32_u24 v20, 16, v1
v_add_u32 v20, s61, v20
s_mov_b64 exec, 0xf
ds_write_b32 v20, v15
ds_write_b32 v20, v16 offset:64
s_mov_b64 exec, 1
ds_write_b32 v20, v60 offset:128
ds_write_b32 v20, v61 offset:144
ds_write_b32 v20, v62 offset:160
ds_write_b32 v20, v63 offset:176
s_mov_b64 exec, -1
v_and_b32 v18, 3, v0
v_mul_u32_u24 v18, 16, v18
v_add_u32 v18, 47104, v18
s_waitcnt lgkmcnt(0)
s_barrier
ds_read_b128 v[96:99], v18 offset:0
ds_read_b128 v[104:107], v18 offset:64
ds_read_b128 v[28:31], v18 offset:128
s_waitcnt lgkmcnt(0)
v_max3_f32 v36, v96, v97, v98
v_max_f32 v36, v36, v99
v_sub_f32 v96, v96, v36
v_sub_f32 v97, v97, v36
v_sub_f32 v98, v98, v36
v_sub_f32 v99, v99, v36
v_exp_f32 v96, v96
v_exp_f32 v97, v97
v_exp_f32 v98, v98
v_exp_f32 v99, v99
s_nop 0
v_mul_f32 v37, v96, v104
v_mul_f32 v38, v96, v28
v_fmac_f32 v37, v97, v105
v_fmac_f32 v38, v97, v29
v_fmac_f32 v37, v98, v106
v_fmac_f32 v38, v98, v30
v_fmac_f32 v37, v99, v107
v_fmac_f32 v38, v99, v31
s_branch L_vlast_back
.section .rodata,"a"
.p2align 6
.amdhsa_kernel standalone__kv_cache_quant_int4_int2_kv_with_per_channel_or_per_token_scales__decode_kernel
  .amdhsa_next_free_vgpr 176
  .amdhsa_next_free_sgpr 70
  .amdhsa_accum_offset 176
  .amdhsa_group_segment_fixed_size 0
  .amdhsa_kernarg_size 80
  .amdhsa_user_sgpr_count 2
  .amdhsa_user_sgpr_kernarg_segment_ptr 1
  .amdhsa_system_sgpr_workgroup_id_x 1
  .amdhsa_float_denorm_mode_32 3
.end_amdhsa_kernel
```
